```python
import torch

def _softmax(x, axis=-1):
    return torch.softmax(x, dim=axis)
def _gelu(x):
    return torch.nn.functional.gelu(x, approximate="tanh")
def _silu(x):
    return torch.nn.functional.silu(x)
def _sigmoid(x):
    return torch.sigmoid(x)
def _layernorm(x, axis=-1, eps=1e-5):
    m = x.mean(dim=axis, keepdim=True)
    v = x.var(dim=axis, keepdim=True, unbiased=False)
    return (x - m) / torch.sqrt(v + eps)
def _scatter_add(tgt, idx, src, axis=0):
    return tgt.clone().index_add_(axis, idx, src)
def _segment_sum(src, seg, n):
    out = torch.zeros((n,) + src.shape[1:], dtype=src.dtype)
    return out.index_add_(0, seg, src)
def _pad(x, pw):
    flat = tuple(v for pair in reversed(pw) for v in pair)
    return torch.nn.functional.pad(x, flat)

kernel_name = 'standalone__linear_kernel_rfa__decode'

def setup_inputs():

    _w = (lambda a: (lambda t: t.to(torch.bfloat16) if t.is_floating_point() else t)(torch.as_tensor(a)))
    B, H, Sq, Sk, D, M = 4, 32, 1, 4096, 128, 8
    return {
        "q": _w((lambda *s: torch.randn(*s, dtype=torch.bfloat16) * 0.05)(B, H, Sq, D)),
        "k": _w((lambda *s: torch.randn(*s, dtype=torch.bfloat16) * 0.4)(B, H, Sk, D)),
        "v": _w((lambda *s: torch.randn(*s, dtype=torch.bfloat16) * 0.4)(B, H, Sk, D)),
        "omega": _w((lambda *s: torch.randn(*s, dtype=torch.bfloat16) * 0.8)(M, D)),
    }

def reference(q, k, v, omega):
    d = q.shape[-1]
    m = omega.shape[0]
    scale = float(d) ** -0.25
    qs = q * scale
    ks = k * scale
    q_proj = torch.einsum("bhsd,md->bhsm", qs, omega)
    k_proj = torch.einsum("bhsd,md->bhsm", ks, omega)
    q_sq = 0.5 * torch.einsum("bhsd,bhsd->bhs", qs, qs)[..., None]
    k_sq = 0.5 * torch.einsum("bhsd,bhsd->bhs", ks, ks)[..., None]
    inv_sqrt_m = float(m) ** -0.5
    phi_q = torch.exp(q_proj - q_sq) * inv_sqrt_m + 1e-6
    phi_k = torch.exp(k_proj - k_sq) * inv_sqrt_m + 1e-6
    kv = torch.einsum("bhsm,bhsd->bhmd", phi_k, v)
    z  = torch.einsum("bhsm->bhm", phi_k)
    num = torch.einsum("bhqm,bhmd->bhqd", phi_q, kv)
    den = torch.einsum("bhqm,bhm->bhq", phi_q, z)[..., None] + 1e-6
    return num / den
```

```asm
; @launch grid=(256,1,1) block=(256,1,1) lds=33808
.amdgcn_target "amdgcn-amd-amdhsa--gfx950"
.text
.globl standalone__linear_kernel_rfa__decode_kernel
.p2align 8
.type standalone__linear_kernel_rfa__decode_kernel,@function
standalone__linear_kernel_rfa__decode_kernel:
  s_load_dwordx8 s[4:11], s[0:1], 0
  s_load_dwordx4 s[12:15], s[0:1], 32
  s_load_dwordx2 s[16:17], s[0:1], 48
  v_lshrrev_b32 v2, 6, v0
  s_cmp_ge_u32 s2, 256
  s_cbranch_scc1 L_end
  v_readfirstlane_b32 s40, v2
  v_lshlrev_b32 v53, 3, v0
  v_and_b32 v0, 63, v0
  s_lshr_b32 s38, s2, 1
  s_and_b32 s39, s2, 1
  v_bfrev_b32 v48, v2
  v_lshrrev_b32 v48, 22, v48
  v_lshrrev_b32 v1, 4, v0
  v_lshlrev_b32 v1, 6, v1
  v_and_b32 v3, 3, v0
  v_bfe_u32 v46, v0, 2, 2
  v_lshl_or_b32 v5, v3, 4, v1
  v_or_b32 v59, v5, v48
  v_lshl_or_b32 v59, v46, 12, v59
  v_mov_b32 v8, v59
  v_lshl_or_b32 v6, v46, 4, v1
  v_lshl_or_b32 v6, v3, 8, v6
  s_lshl_b32 s42, s38, 20
  s_lshl_b32 s3, s39, 15
  s_sub_u32 s22, 0x100000, s3
  s_add_u32 s42, s42, s3
  s_mov_b32 s36, 0
  s_lshl_b32 s43, s38, 8
  s_lshl_b32 s3, s38, 10
  s_mov_b32 s23, 0x20000
  s_mov_b32 s30, 256
  s_mov_b32 s31, 0x20000
  s_mov_b32 s34, 2048
  s_mov_b32 s35, 0x20000
  s_mov_b32 s46, 1024
  s_mov_b32 s47, 0x20000
  s_waitcnt lgkmcnt(0)
  s_add_u32 s44, s16, s3
  s_addc_u32 s45, s17, 0
  buffer_load_dword v52, v53, s[44:47], 0 offen offset:4 sc0 sc1
  s_add_u32 s20, s6, s42
  s_addc_u32 s21, s7, 0
  buffer_load_dwordx4 v[68:71], v8, s[20:23], s36 offen nt
  s_mov_b32 s32, s10
  s_mov_b32 s33, s11
  buffer_load_dwordx4 v[12:15], v6, s[32:35], 0 offen
  buffer_load_dwordx4 v[16:19], v6, s[32:35], 0 offen offset:1024
  s_add_u32 s28, s4, s43
  s_addc_u32 s29, s5, 0
  buffer_load_dwordx4 v[32:35], v5, s[28:31], 0 offen
  buffer_load_dwordx4 v[72:75], v8, s[20:23], s36 offen offset:2048 nt
  buffer_load_dwordx4 v[76:79], v8, s[20:23], s36 offen offset:1024 nt
  buffer_load_dwordx4 v[80:83], v8, s[20:23], s36 offen offset:3072 nt
  s_bitset1_b32 s36, 16
  buffer_load_dwordx4 v[84:87], v8, s[20:23], s36 offen nt
  buffer_load_dwordx4 v[88:91], v8, s[20:23], s36 offen offset:2048 nt
  s_add_u32 s24, s8, s42
  s_addc_u32 s25, s9, 0
  s_add_u32 s28, s12, s43
  s_addc_u32 s29, s13, 0
  s_lshl_b32 s27, s2, 2
  s_add_u32 s27, s27, s40
  s_and_b32 s18, s27, 0x3e3
  s_cmp_lg_u32 s18, 2
  s_cbranch_scc1 L_noref
  v_mul_u32_u24 v9, 0x1100, v0
  v_add_u32 v9, 0x40000, v9
  s_mov_b32 s51, 0
  s_mov_b32 s52, 0
  s_mov_b32 exec_hi, 0
  global_load_dword v9, v9, s[16:17] sc0 sc1
  s_mov_b64 exec, -1
L_noref:
  s_getreg_b32 s3, hwreg(HW_REG_XCC_ID, 0, 3)
  s_mul_i32 s3, s3, 0x1100
  s_add_u32 s3, s3, 0x20000
  v_mov_b32 v56, s3
  s_mov_b32 s48, 0
  s_mov_b32 s49, 1
  s_mov_b32 s50, 0
  s_lshr_b32 s26, s38, 2
  s_and_b32 s26, s26, 3
  s_add_u32 s26, s26, 12
  s_cmp_lt_u32 s40, 2
  s_cselect_b32 s26, s26, -1
  s_cselect_b32 s56, 8, -1
  v_mov_b32 v57, 0
  v_mov_b32 v58, 0
  v_lshrrev_b32 v54, 6, v53
  v_lshlrev_b32 v54, 4, v54
  v_and_b32 v46, 1, v46
  v_lshl_add_u32 v54, v46, 8, v54
  v_lshl_add_u32 v54, v3, 2, v54
  s_mul_i32 s3, s40, 8448
  v_lshl_add_u32 v55, v0, 4, s3
  v_lshl_add_u32 v7, v0, 2, s3
  v_and_b32 v46, 15, v0
  v_lshl_or_b32 v48, v46, 4, v48
  v_lshl_or_b32 v48, v1, 6, v48
  v_mov_b32 v4, 0xbe1837f0
  s_mov_b32 s41, 0x3edb9ada
  v_mov_b32 v3, 0
  v_mov_b32 v36, 0
  v_mov_b32 v40, 0
  v_mov_b32 v37, 0
  v_mov_b32 v41, 0
  v_mov_b32 v38, 0
  v_mov_b32 v42, 0
  v_mov_b32 v39, 0
  v_mov_b32 v43, 0
  v_and_b32 v46, 1, v0
  v_cmp_eq_u32 vcc, 1, v46
  v_mov_b32 v28, 0x0c0c0100
  v_mov_b32 v29, 0x01000c0c
  v_cndmask_b32 v28, v28, v29, vcc
  v_mov_b32 v29, 0x0c0c0302
  v_mov_b32 v30, 0x03020c0c
  v_cndmask_b32 v29, v29, v30, vcc
  v_mov_b32 v30, 0x0c0c0c0c
  v_bfe_u32 v46, v0, 1, 2
  v_cmp_eq_u32 vcc, 0, v46
  s_nop 1
  v_cndmask_b32 v20, v30, v28, vcc
  v_cndmask_b32 v24, v30, v29, vcc
  v_cmp_eq_u32 vcc, 1, v46
  s_nop 1
  v_cndmask_b32 v21, v30, v28, vcc
  v_cndmask_b32 v25, v30, v29, vcc
  v_cmp_eq_u32 vcc, 2, v46
  s_nop 1
  v_cndmask_b32 v22, v30, v28, vcc
  v_cndmask_b32 v26, v30, v29, vcc
  v_cmp_eq_u32 vcc, 3, v46
  s_nop 1
  v_cndmask_b32 v23, v30, v28, vcc
  v_cndmask_b32 v27, v30, v29, vcc
  s_waitcnt vmcnt(8)
  buffer_load_dwordx4 v[92:95], v8, s[20:23], s36 offen offset:1024 nt
  s_waitcnt vmcnt(6)
  v_dot2_f32_bf16 v1, v32, v32, 0
  v_dot2_f32_bf16 v1, v33, v33, v1
  v_dot2_f32_bf16 v1, v34, v34, v1
  v_dot2_f32_bf16 v1, v35, v35, v1
  s_mov_b64 vcc, -1
  s_nop 1
  v_mfma_f32_16x16x4_f32 v[28:31], v1, v4, 0
  v_mfma_f32_16x16x32_bf16 v[60:63], v[32:35], v[12:15], v[28:31]
  v_mfma_f32_16x16x32_bf16 v[64:67], v[32:35], v[16:19], v[28:31]
  s_waitcnt vmcnt(5)
  buffer_load_dwordx4 v[96:99], v8, s[20:23], s36 offen offset:3072 nt
  s_or_b32 s36, s36, 0xfff1bfff
  s_add_u32 s36, s36, 1
  s_and_b32 s36, s36, 0xe4000
  s_nop 7
  v_add_f32_dpp v50, v61, v60 row_ror:12 row_mask:0xf bank_mask:0xf
  v_add_f32_dpp v51, v64, v65 row_ror:4 row_mask:0xf bank_mask:0xf
  s_nop 0
  v_add_f32_dpp v50, v62, v50 row_ror:8 row_mask:0xf bank_mask:0xf
  v_add_f32_dpp v51, v66, v51 row_ror:12 row_mask:0xf bank_mask:0xf
  s_nop 0
  v_add_f32_dpp v2, v63, v50 row_ror:4 row_mask:0xf bank_mask:0x1
  s_nop 1
  v_add_f32_dpp v2, v67, v51 row_ror:8 row_mask:0xf bank_mask:0x2
  s_nop 1
  v_mov_b32_dpp v2, v2 row_ror:8 row_mask:0xf bank_mask:0xc
  v_mul_f32 v2, s41, v2
  v_exp_f32 v2, v2
  v_mov_b32 v46, 0x358637bd
  v_fmac_f32 v46, 0x3eb504f3, v2
  v_mul_f32 v5, 0x3eb504f3, v46
  v_mul_f32 v6, 0x358637bd, v46
L_pass:
  v_dot2_f32_bf16 v1, v68, v68, 0
  v_dot2_f32_bf16 v1, v69, v69, v1
  v_dot2_f32_bf16 v1, v70, v70, v1
  v_dot2_f32_bf16 v1, v71, v71, v1
  s_mov_b32 s37, 16
  s_nop 1
  v_mfma_f32_16x16x4_f32 v[28:31], v1, v4, 0
  v_mfma_f32_16x16x32_bf16 v[60:63], v[68:71], v[12:15], v[28:31]
  v_mfma_f32_16x16x32_bf16 v[64:67], v[68:71], v[16:19], v[28:31]
L_kloop:
  s_cmp_eq_u32 s18, 2
  s_cbranch_scc1 L_pubK
  global_load_dword v49, v56, s[16:17] nt
L_pubK_back:
  s_waitcnt vmcnt(5)
  buffer_load_dwordx4 v[68:71], v8, s[20:23], s36 offen nt
  v_dot2_f32_bf16 v1, v72, v72, 0
  v_add_f32_dpp v47, v47, v47 quad_perm:[1,0,3,2] row_mask:0xf bank_mask:0xf
  v_dot2_f32_bf16 v1, v73, v73, v1
  v_dot2_f32_bf16 v1, v74, v74, v1
  v_add_f32_dpp v47, v47, v47 quad_perm:[2,3,0,1] row_mask:0xf bank_mask:0xf
  v_dot2_f32_bf16 v1, v75, v75, v1
  v_add_f32_dpp v50, v61, v60 row_ror:12 row_mask:0xf bank_mask:0xf
  v_add_f32_dpp v47, v47, v47 row_half_mirror row_mask:0xf bank_mask:0xf
  v_add_f32_dpp v51, v64, v65 row_ror:4 row_mask:0xf bank_mask:0xf
  v_mfma_f32_16x16x4_f32 v[28:31], v1, v4, 0
  v_add_f32_dpp v50, v62, v50 row_ror:8 row_mask:0xf bank_mask:0xf
  v_add_f32_dpp v51, v66, v51 row_ror:12 row_mask:0xf bank_mask:0xf
  v_cvt_pk_bf16_f32 v44, v46, v47
  v_add_f32_dpp v2, v63, v50 row_ror:4 row_mask:0xf bank_mask:0x1
  v_mfma_f32_16x16x32_bf16 v[60:63], v[72:75], v[12:15], v[28:31]
  ds_write_b32 v7, v44 offset:0
  v_add_f32_dpp v2, v67, v51 row_ror:8 row_mask:0xf bank_mask:0x2
  v_mfma_f32_16x16x32_bf16 v[64:67], v[72:75], v[16:19], v[28:31]
  s_cbranch_vccnz L_w1
  s_waitcnt vmcnt(5)
L_w1:
  s_waitcnt vmcnt(6)
  buffer_load_dwordx4 v[72:75], v8, s[20:23], s36 offen offset:2048 nt
  v_dot2_f32_bf16 v1, v76, v76, 0
  v_dot2_f32_bf16 v1, v77, v77, v1
  v_dot2_f32_bf16 v1, v78, v78, v1
  v_dot2_f32_bf16 v1, v79, v79, v1
  s_nop 0
  v_add_f32_dpp v50, v60, v62 row_ror:8 row_mask:0xf bank_mask:0xf
  v_add_f32_dpp v51, v64, v67 row_ror:12 row_mask:0xf bank_mask:0xf
  v_mfma_f32_16x16x4_f32 v[28:31], v1, v4, 0
  v_add_f32_dpp v50, v61, v50 row_ror:4 row_mask:0xf bank_mask:0xf
  v_add_f32_dpp v51, v65, v51 row_ror:8 row_mask:0xf bank_mask:0xf
  s_nop 0
  v_add_f32_dpp v2, v63, v50 row_ror:12 row_mask:0xf bank_mask:0x4
  v_mfma_f32_16x16x32_bf16 v[60:63], v[76:79], v[12:15], v[28:31]
  s_nop 0
  v_add_f32_dpp v2, v66, v51 row_ror:4 row_mask:0xf bank_mask:0x8
  v_mul_f32 v2, s41, v2
  v_exp_f32 v2, v2
  v_mfma_f32_16x16x32_bf16 v[64:67], v[76:79], v[16:19], v[28:31]
  v_fma_f32 v46, v2, v5, v6
  v_add_f32 v3, v3, v46
  s_waitcnt vmcnt(5)
  buffer_load_dwordx4 v[76:79], v8, s[20:23], s36 offen offset:1024 nt
  v_dot2_f32_bf16 v1, v80, v80, 0
  v_add_f32_dpp v46, v46, v46 quad_perm:[1,0,3,2] row_mask:0xf bank_mask:0xf
  v_dot2_f32_bf16 v1, v81, v81, v1
  v_dot2_f32_bf16 v1, v82, v82, v1
  v_add_f32_dpp v46, v46, v46 quad_perm:[2,3,0,1] row_mask:0xf bank_mask:0xf
  v_dot2_f32_bf16 v1, v83, v83, v1
  v_add_f32_dpp v50, v61, v60 row_ror:12 row_mask:0xf bank_mask:0xf
  v_add_f32_dpp v46, v46, v46 row_half_mirror row_mask:0xf bank_mask:0xf
  v_add_f32_dpp v51, v64, v65 row_ror:4 row_mask:0xf bank_mask:0xf
  v_mfma_f32_16x16x4_f32 v[28:31], v1, v4, 0
  v_add_f32_dpp v50, v62, v50 row_ror:8 row_mask:0xf bank_mask:0xf
  v_add_f32_dpp v51, v66, v51 row_ror:12 row_mask:0xf bank_mask:0xf
  s_nop 0
  v_add_f32_dpp v2, v63, v50 row_ror:4 row_mask:0xf bank_mask:0x1
  v_mfma_f32_16x16x32_bf16 v[60:63], v[80:83], v[12:15], v[28:31]
  s_nop 0
  v_add_f32_dpp v2, v67, v51 row_ror:8 row_mask:0xf bank_mask:0x2
  v_mfma_f32_16x16x32_bf16 v[64:67], v[80:83], v[16:19], v[28:31]
  s_cbranch_vccnz L_w2
  s_waitcnt vmcnt(5)
L_w2:
  s_waitcnt vmcnt(6)
  buffer_load_dwordx4 v[80:83], v8, s[20:23], s36 offen offset:3072 nt
  s_bitset1_b32 s36, 16
  v_dot2_f32_bf16 v1, v84, v84, 0
  v_dot2_f32_bf16 v1, v85, v85, v1
  v_dot2_f32_bf16 v1, v86, v86, v1
  v_dot2_f32_bf16 v1, v87, v87, v1
  s_nop 0
  v_add_f32_dpp v50, v60, v62 row_ror:8 row_mask:0xf bank_mask:0xf
  v_add_f32_dpp v51, v64, v67 row_ror:12 row_mask:0xf bank_mask:0xf
  v_mfma_f32_16x16x4_f32 v[28:31], v1, v4, 0
  v_add_f32_dpp v50, v61, v50 row_ror:4 row_mask:0xf bank_mask:0xf
  v_add_f32_dpp v51, v65, v51 row_ror:8 row_mask:0xf bank_mask:0xf
  s_nop 0
  v_add_f32_dpp v2, v63, v50 row_ror:12 row_mask:0xf bank_mask:0x4
  v_mfma_f32_16x16x32_bf16 v[60:63], v[84:87], v[12:15], v[28:31]
  s_nop 0
  v_add_f32_dpp v2, v66, v51 row_ror:4 row_mask:0xf bank_mask:0x8
  v_mul_f32 v2, s41, v2
  v_exp_f32 v2, v2
  v_mfma_f32_16x16x32_bf16 v[64:67], v[84:87], v[16:19], v[28:31]
  v_fma_f32 v47, v2, v5, v6
  v_add_f32 v3, v3, v47
  s_waitcnt vmcnt(5)
  buffer_load_dwordx4 v[84:87], v8, s[20:23], s36 offen nt
  v_dot2_f32_bf16 v1, v88, v88, 0
  v_add_f32_dpp v47, v47, v47 quad_perm:[1,0,3,2] row_mask:0xf bank_mask:0xf
  v_dot2_f32_bf16 v1, v89, v89, v1
  v_dot2_f32_bf16 v1, v90, v90, v1
  v_add_f32_dpp v47, v47, v47 quad_perm:[2,3,0,1] row_mask:0xf bank_mask:0xf
  v_dot2_f32_bf16 v1, v91, v91, v1
  v_add_f32_dpp v50, v61, v60 row_ror:12 row_mask:0xf bank_mask:0xf
  v_add_f32_dpp v47, v47, v47 row_half_mirror row_mask:0xf bank_mask:0xf
  v_add_f32_dpp v51, v64, v65 row_ror:4 row_mask:0xf bank_mask:0xf
  v_mfma_f32_16x16x4_f32 v[28:31], v1, v4, 0
  v_add_f32_dpp v50, v62, v50 row_ror:8 row_mask:0xf bank_mask:0xf
  v_add_f32_dpp v51, v66, v51 row_ror:12 row_mask:0xf bank_mask:0xf
  v_cvt_pk_bf16_f32 v44, v46, v47
  v_add_f32_dpp v2, v63, v50 row_ror:4 row_mask:0xf bank_mask:0x1
  v_mfma_f32_16x16x32_bf16 v[60:63], v[88:91], v[12:15], v[28:31]
  ds_write_b32 v7, v44 offset:256
  v_add_f32_dpp v2, v67, v51 row_ror:8 row_mask:0xf bank_mask:0x2
  v_mfma_f32_16x16x32_bf16 v[64:67], v[88:91], v[16:19], v[28:31]
  s_cbranch_vccnz L_w3
  s_waitcnt vmcnt(4)
L_w3:
  s_waitcnt vmcnt(6)
  buffer_load_dwordx4 v[88:91], v8, s[20:23], s36 offen offset:2048 nt
  v_dot2_f32_bf16 v1, v92, v92, 0
  v_dot2_f32_bf16 v1, v93, v93, v1
  v_dot2_f32_bf16 v1, v94, v94, v1
  v_dot2_f32_bf16 v1, v95, v95, v1
  s_nop 0
  v_add_f32_dpp v50, v60, v62 row_ror:8 row_mask:0xf bank_mask:0xf
  v_add_f32_dpp v51, v64, v67 row_ror:12 row_mask:0xf bank_mask:0xf
  v_mfma_f32_16x16x4_f32 v[28:31], v1, v4, 0
  v_add_f32_dpp v50, v61, v50 row_ror:4 row_mask:0xf bank_mask:0xf
  v_add_f32_dpp v51, v65, v51 row_ror:8 row_mask:0xf bank_mask:0xf
  s_nop 0
  v_add_f32_dpp v2, v63, v50 row_ror:12 row_mask:0xf bank_mask:0x4
  v_mfma_f32_16x16x32_bf16 v[60:63], v[92:95], v[12:15], v[28:31]
  s_nop 0
  v_add_f32_dpp v2, v66, v51 row_ror:4 row_mask:0xf bank_mask:0x8
  v_mul_f32 v2, s41, v2
  v_exp_f32 v2, v2
  v_mfma_f32_16x16x32_bf16 v[64:67], v[92:95], v[16:19], v[28:31]
  v_fma_f32 v46, v2, v5, v6
  v_add_f32 v3, v3, v46
  s_cbranch_vccnz L_w4
  s_waitcnt vmcnt(4)
L_w4:
  s_waitcnt vmcnt(5)
  buffer_load_dwordx4 v[92:95], v8, s[20:23], s36 offen offset:1024 nt
  v_dot2_f32_bf16 v1, v96, v96, 0
  v_add_f32_dpp v46, v46, v46 quad_perm:[1,0,3,2] row_mask:0xf bank_mask:0xf
  v_dot2_f32_bf16 v1, v97, v97, v1
  v_dot2_f32_bf16 v1, v98, v98, v1
  v_add_f32_dpp v46, v46, v46 quad_perm:[2,3,0,1] row_mask:0xf bank_mask:0xf
  v_dot2_f32_bf16 v1, v99, v99, v1
  v_add_f32_dpp v50, v61, v60 row_ror:12 row_mask:0xf bank_mask:0xf
  v_add_f32_dpp v46, v46, v46 row_half_mirror row_mask:0xf bank_mask:0xf
  v_add_f32_dpp v51, v64, v65 row_ror:4 row_mask:0xf bank_mask:0xf
  v_mfma_f32_16x16x4_f32 v[28:31], v1, v4, 0
  v_add_f32_dpp v50, v62, v50 row_ror:8 row_mask:0xf bank_mask:0xf
  v_add_f32_dpp v51, v66, v51 row_ror:12 row_mask:0xf bank_mask:0xf
  s_nop 0
  v_add_f32_dpp v2, v63, v50 row_ror:4 row_mask:0xf bank_mask:0x1
  v_mfma_f32_16x16x32_bf16 v[60:63], v[96:99], v[12:15], v[28:31]
  s_nop 0
  v_add_f32_dpp v2, v67, v51 row_ror:8 row_mask:0xf bank_mask:0x2
  v_mfma_f32_16x16x32_bf16 v[64:67], v[96:99], v[16:19], v[28:31]
  s_waitcnt vmcnt(5)
  buffer_load_dwordx4 v[96:99], v8, s[20:23], s36 offen offset:3072 nt
  s_or_b32 s36, s36, 0xfff1bfff
  s_add_u32 s36, s36, 1
  s_and_b32 s36, s36, 0xe4000
  s_cmp_eq_u32 s37, 2
  s_cbranch_scc1 L_tov
L_tov_back:
  v_dot2_f32_bf16 v1, v68, v68, 0
  v_dot2_f32_bf16 v1, v69, v69, v1
  v_dot2_f32_bf16 v1, v70, v70, v1
  v_dot2_f32_bf16 v1, v71, v71, v1
  s_nop 0
  v_add_f32_dpp v50, v60, v62 row_ror:8 row_mask:0xf bank_mask:0xf
  v_add_f32_dpp v51, v64, v67 row_ror:12 row_mask:0xf bank_mask:0xf
  v_mfma_f32_16x16x4_f32 v[28:31], v1, v4, 0
  v_add_f32_dpp v50, v61, v50 row_ror:4 row_mask:0xf bank_mask:0xf
  v_add_f32_dpp v51, v65, v51 row_ror:8 row_mask:0xf bank_mask:0xf
  s_nop 0
  v_add_f32_dpp v2, v63, v50 row_ror:12 row_mask:0xf bank_mask:0x4
  v_mfma_f32_16x16x32_bf16 v[60:63], v[68:71], v[12:15], v[28:31]
  s_nop 0
  v_add_f32_dpp v2, v66, v51 row_ror:4 row_mask:0xf bank_mask:0x8
  v_mul_f32 v2, s41, v2
  v_exp_f32 v2, v2
  v_mfma_f32_16x16x32_bf16 v[64:67], v[68:71], v[16:19], v[28:31]
  v_fma_f32 v47, v2, v5, v6
  v_add_f32 v3, v3, v47
L_kend:
  v_add_u32 v7, 512, v7
  v_readfirstlane_b32 s3, v49
  s_add_u32 s48, s48, 1
  s_cmp_eq_u32 s48, 1
  s_cselect_b32 s50, s3, s50
  s_cmp_eq_u32 s3, s50
  s_cselect_b32 s49, s49, 0
  s_and_b32 s57, s48, -2
  s_cmp_lg_u32 s49, 0
  s_cselect_b32 s3, s57, s3
  s_cmp_ge_u32 s3, s48
  s_cselect_b64 vcc, -1, 0
  s_sub_u32 s37, s37, 1
  s_cmp_eq_u32 s37, s26
  s_cbranch_scc1 L_look
  s_cmp_gt_u32 s3, s48
  s_cbranch_scc1 L_kfar
  s_cmp_lg_u32 s37, 0
  s_cbranch_scc1 L_kloop
L_kdone:
  v_add_f32_dpp v2, v3, v3 quad_perm:[1,0,3,2] row_mask:0xf bank_mask:0xf
  v_add_f32_dpp v47, v47, v47 quad_perm:[1,0,3,2] row_mask:0xf bank_mask:0xf
  v_subrev_u32 v7, 0x1f00, v7
  v_add_f32_dpp v2, v2, v2 quad_perm:[2,3,0,1] row_mask:0xf bank_mask:0xf
  v_add_f32_dpp v47, v47, v47 quad_perm:[2,3,0,1] row_mask:0xf bank_mask:0xf
  ds_read_b32 v44, v7
  v_add_f32_dpp v2, v2, v2 row_half_mirror row_mask:0xf bank_mask:0xf
  v_add_f32_dpp v47, v47, v47 row_half_mirror row_mask:0xf bank_mask:0xf
  ds_read_b32 v45, v7 offset:256
  v_add_f32_dpp v2, v2, v2 row_mirror row_mask:0xf bank_mask:0xf
  v_cvt_pk_bf16_f32 v1, v46, v47
  ds_write_b32 v7, v1 offset:7936
  v_add_f32_dpp v2, v2, v2 row_bcast:15 row_mask:0xa bank_mask:0xf
  s_lshl_b32 s3, s40, 2
  v_mov_b32 v46, s3
  v_add_f32_dpp v2, v2, v2 row_bcast:31 row_mask:0xc bank_mask:0xf
  s_mov_b32 s37, 16
  v_readlane_b32 s3, v2, 63
  s_waitcnt lgkmcnt(0)
  v_perm_b32 v32, v44, v44, v20
  v_perm_b32 v33, v44, v44, v21
  v_perm_b32 v34, v44, v44, v22
  v_perm_b32 v35, v44, v44, v23
  v_min_u32 v58, 1, v58
  s_bitset0_b32 s3, 31
  v_lshl_or_b32 v2, v58, 31, s3
  ds_write_b32 v46, v2 offset:33792
  s_cmp_eq_u32 s27, 7
  s_cbranch_scc1 L_flag1
L_vloop:
  s_cmp_eq_u32 s18, 2
  s_cbranch_scc1 L_pubV
  global_load_dword v49, v56, s[16:17] nt
L_pubV_back:
  v_mfma_f32_16x16x32_bf16 v[36:39], v[32:35], v[68:71], v[36:39]
  s_waitcnt vmcnt(5)
  buffer_load_dwordx4 v[68:71], v8, s[20:23], s36 offen nt
  v_mfma_f32_16x16x32_bf16 v[40:43], v[32:35], v[72:75], v[40:43]
  v_perm_b32 v32, v44, v44, v24
  v_perm_b32 v33, v44, v44, v25
  v_perm_b32 v34, v44, v44, v26
  v_perm_b32 v35, v44, v44, v27
  ds_read_b32 v44, v7 offset:512
  s_cbranch_vccnz L_w5
  s_waitcnt vmcnt(5)
L_w5:
  s_waitcnt vmcnt(6)
  buffer_load_dwordx4 v[72:75], v8, s[20:23], s36 offen offset:2048 nt
  v_mfma_f32_16x16x32_bf16 v[36:39], v[32:35], v[76:79], v[36:39]
  s_waitcnt vmcnt(5)
  buffer_load_dwordx4 v[76:79], v8, s[20:23], s36 offen offset:1024 nt
  v_mfma_f32_16x16x32_bf16 v[40:43], v[32:35], v[80:83], v[40:43]
  s_waitcnt lgkmcnt(1)
  v_perm_b32 v32, v45, v45, v20
  v_perm_b32 v33, v45, v45, v21
  v_perm_b32 v34, v45, v45, v22
  v_perm_b32 v35, v45, v45, v23
  s_cbranch_vccnz L_w6
  s_waitcnt vmcnt(5)
L_w6:
  s_waitcnt vmcnt(6)
  buffer_load_dwordx4 v[80:83], v8, s[20:23], s36 offen offset:3072 nt
  s_bitset1_b32 s36, 16
  v_mfma_f32_16x16x32_bf16 v[36:39], v[32:35], v[84:87], v[36:39]
  s_waitcnt vmcnt(5)
  buffer_load_dwordx4 v[84:87], v8, s[20:23], s36 offen nt
  v_mfma_f32_16x16x32_bf16 v[40:43], v[32:35], v[88:91], v[40:43]
  v_perm_b32 v32, v45, v45, v24
  v_perm_b32 v33, v45, v45, v25
  v_perm_b32 v34, v45, v45, v26
  v_perm_b32 v35, v45, v45, v27
  ds_read_b32 v45, v7 offset:768
  s_cbranch_vccnz L_w7
  s_waitcnt vmcnt(4)
L_w7:
  s_waitcnt vmcnt(6)
  buffer_load_dwordx4 v[88:91], v8, s[20:23], s36 offen offset:2048 nt
  v_mfma_f32_16x16x32_bf16 v[36:39], v[32:35], v[92:95], v[36:39]
  s_cbranch_vccnz L_w8
  s_waitcnt vmcnt(4)
L_w8:
  s_waitcnt vmcnt(5)
  buffer_load_dwordx4 v[92:95], v8, s[20:23], s36 offen offset:1024 nt
  v_mfma_f32_16x16x32_bf16 v[40:43], v[32:35], v[96:99], v[40:43]
  s_waitcnt lgkmcnt(1)
  v_perm_b32 v32, v44, v44, v20
  v_perm_b32 v33, v44, v44, v21
  v_perm_b32 v34, v44, v44, v22
  v_perm_b32 v35, v44, v44, v23
  v_add_u32 v7, 512, v7
  s_sub_u32 s37, s37, 1
  s_cbranch_vccnz L_w9
  s_waitcnt vmcnt(4)
L_w9:
  s_waitcnt vmcnt(5)
  buffer_load_dwordx4 v[96:99], v8, s[20:23], s36 offen offset:3072 nt
  s_or_b32 s36, s36, 0xfff1bfff
  s_add_u32 s36, s36, 1
  s_and_b32 s36, s36, 0xe4000
L_vend:
  v_readfirstlane_b32 s3, v49
  s_add_u32 s48, s48, 1
  s_cmp_lg_u32 s49, 0
  s_cbranch_scc1 L_invV
L_invV_back:
  s_cmp_ge_u32 s3, s48
  s_cselect_b64 vcc, -1, 0
  s_cmp_eq_u32 s37, s56
  s_cbranch_scc1 L_chk
  s_cmp_gt_u32 s3, s48
  s_cbranch_scc1 L_vfar
  s_cmp_lg_u32 s37, 1
  s_cbranch_scc1 L_vloop
L_vdone:
  s_cmp_eq_u32 s18, 2
  v_mfma_f32_16x16x32_bf16 v[36:39], v[32:35], v[68:71], v[36:39]
  s_waitcnt vmcnt(6)
  v_mfma_f32_16x16x32_bf16 v[40:43], v[32:35], v[72:75], v[40:43]
  v_perm_b32 v32, v44, v44, v24
  v_perm_b32 v33, v44, v44, v25
  v_perm_b32 v34, v44, v44, v26
  v_perm_b32 v35, v44, v44, v27
  s_waitcnt vmcnt(5)
  s_nop 0
  v_mfma_f32_16x16x32_bf16 v[36:39], v[32:35], v[76:79], v[36:39]
  s_waitcnt vmcnt(4)
  v_mfma_f32_16x16x32_bf16 v[40:43], v[32:35], v[80:83], v[40:43]
  s_waitcnt lgkmcnt(0)
  v_perm_b32 v32, v45, v45, v20
  v_perm_b32 v33, v45, v45, v21
  v_perm_b32 v34, v45, v45, v22
  v_perm_b32 v35, v45, v45, v23
  s_waitcnt vmcnt(3)
  s_nop 0
  v_mfma_f32_16x16x32_bf16 v[36:39], v[32:35], v[84:87], v[36:39]
  s_waitcnt vmcnt(2)
  v_mfma_f32_16x16x32_bf16 v[40:43], v[32:35], v[88:91], v[40:43]
  v_perm_b32 v32, v45, v45, v24
  v_perm_b32 v33, v45, v45, v25
  v_perm_b32 v34, v45, v45, v26
  v_perm_b32 v35, v45, v45, v27
  s_waitcnt vmcnt(1)
  buffer_load_dwordx2 v[10:11], v53, s[44:47], 0 offen sc0 sc1
  s_cbranch_scc1 L_pubL
L_pubL_back:
  v_mfma_f32_16x16x32_bf16 v[36:39], v[32:35], v[92:95], v[36:39]
  s_nop 6
  s_mov_b32 exec_hi, 0
  ds_write_b128 v55, v[36:39]
  s_mov_b64 exec, -1
  s_waitcnt vmcnt(1)
  v_mfma_f32_16x16x32_bf16 v[40:43], v[32:35], v[96:99], v[40:43]
  v_not_b32 v46, v52
  v_and_b32 v46, 0x80000000, v46
  s_nop 4
  s_mov_b32 exec_lo, 0
  ds_write_b128 v55, v[40:43]
  s_mov_b64 exec, -1
  s_cmp_gt_u32 s40, 1
  s_waitcnt lgkmcnt(0)
  s_barrier
  ds_read_b128 v[28:31], v57 offset:33792
  s_cbranch_scc1 L_idle
  ds_read2st64_b32 v[60:61], v54 offset0:0 offset1:2
  ds_read2st64_b32 v[62:63], v54 offset0:33 offset1:35
  ds_read2st64_b32 v[64:65], v54 offset0:66 offset1:68
  ds_read2st64_b32 v[66:67], v54 offset0:99 offset1:101
  v_lshrrev_b32 v55, 2, v53
  s_waitcnt lgkmcnt(4)
  v_or_b32 v2, v28, v29
  v_pk_add_f32 v[28:29], v[28:29], v[30:31]
  v_readfirstlane_b32 s3, v2
  v_add_f32 v33, v28, v29
  s_cmp_lt_i32 s3, 0
  s_cbranch_scc1 L_again
  v_or_b32 v35, v33, v46
L_chk2:
  s_cmp_eq_u32 s19, 0
  s_cbranch_scc1 L_poll
  s_waitcnt lgkmcnt(0)
  v_pk_add_f32 v[60:61], v[60:61], v[62:63]
  v_pk_add_f32 v[64:65], v[64:65], v[66:67]
  s_waitcnt vmcnt(0)
  v_xor_b32 v11, v11, v46
  v_pk_add_f32 v[60:61], v[60:61], v[64:65]
  v_cmp_gt_i32 vcc, 0, v11
  v_add_f32 v34, v60, v61
  s_cbranch_vccz L_have
  buffer_atomic_swap_x2 v[34:35], v53, s[44:47], 0 offen sc0 sc1
  v_add_f32 v10, v60, v61
  s_waitcnt vmcnt(0)
  v_xor_b32 v11, v35, v46
  v_cmpx_le_i32 vcc, 0, v11
L_have:
  v_add_f32 v33, v33, v11
  v_add_f32 v32, v34, v10
  v_add_f32 v33, 0x358637bd, v33
  v_rcp_f32 v33, v33
  s_cbranch_execz L_end
  v_mul_f32 v32, v32, v33
  v_cvt_pk_bf16_f32 v32, v32, v32
  buffer_store_short v32, v55, s[28:31], 0 offen sc1
L_end:
  s_endpgm
L_idle:
  s_waitcnt lgkmcnt(0)
  v_or_b32 v2, v28, v29
  s_nop 0
  v_readfirstlane_b32 s3, v2
  s_cmp_lt_i32 s3, 0
  s_cbranch_scc1 L_again
  s_endpgm
L_pubL:
  s_mov_b64 exec, 1
  global_store_dword v56, v49, s[16:17] sc0 sc1
  s_mov_b64 exec, -1
  s_branch L_pubL_back
L_pubK:
  s_add_u32 s3, s48, 1
  v_mov_b32 v49, s3
  s_mov_b64 exec, 1
  global_store_dword v56, v49, s[16:17]
  s_mov_b64 exec, -1
  s_cmp_eq_u32 s48, 0
  s_cbranch_scc1 L_pubK_back
  v_readlane_b32 s3, v9, s48
  s_waitcnt lgkmcnt(0)
  s_sub_u32 s51, s51, s52
  s_cmp_ge_u32 s51, 4
  s_cselect_b64 vcc, -1, 0
  s_mov_b32 s52, s3
  s_mul_i32 s3, s48, 0x1100
  s_add_u32 s3, s3, 0x40000
  s_mov_b32 s51, 1
  s_atomic_add s51, s[16:17], s3 glc
  s_branch L_pubK_back
L_look:
  global_load_dword v58, v57, s[14:15] sc0 sc1
  s_branch L_kloop
L_chk:
  s_load_dword s19, s[14:15], 128
  s_branch L_vloop
L_tov:
  s_mov_b32 s20, s24
  s_mov_b32 s21, s25
  s_mov_b32 s36, 0
  v_mov_b32 v8, v48
  s_cmp_lg_u32 s27, 7
  s_cbranch_scc1 L_tov_back
  s_mov_b32 s19, 1
  s_atomic_add s19, s[14:15], 0 glc
  s_branch L_tov_back
L_flag1:
  s_mov_b32 s19, 1
  s_atomic_add s19, s[14:15], 128
  s_mov_b32 s27, -1
  s_branch L_vloop
L_pubV:
  s_add_u32 s3, s48, 1
  v_mov_b32 v49, s3
  s_mov_b64 exec, 1
  global_store_dword v56, v49, s[16:17]
  s_mov_b64 exec, -1
  v_readlane_b32 s3, v9, s48
  s_waitcnt lgkmcnt(0)
  s_sub_u32 s51, s51, s52
  s_cmp_ge_u32 s51, 4
  s_cselect_b64 vcc, -1, 0
  s_mov_b32 s52, s3
  s_mul_i32 s3, s48, 0x1100
  s_add_u32 s3, s3, 0x40000
  s_mov_b32 s51, 1
  s_atomic_add s51, s[16:17], s3 glc
  s_branch L_pubV_back
L_invV:
  s_cmp_eq_u32 s48, 1
  s_cselect_b32 s50, s3, s50
  s_cmp_eq_u32 s3, s50
  s_cselect_b32 s49, 1, 0
  s_cbranch_scc0 L_invV_back
  s_and_b32 s3, s48, -2
  s_branch L_invV_back
L_poll:
  s_mov_b32 s19, 1
  s_atomic_add s19, s[14:15], 0 glc
  s_waitcnt lgkmcnt(0)
  s_mov_b32 s19, 1
  s_branch L_chk2
L_again:
  s_waitcnt vmcnt(0) lgkmcnt(0)
  s_barrier
  s_mov_b32 s46, 0
  v_mov_b32 v52, -1
  s_mul_i32 s3, s40, 8448
  v_lshl_add_u32 v55, v0, 4, s3
  s_mov_b32 s26, -1
  v_mov_b32 v58, 0
  s_xor_b32 s39, s39, 1
  s_lshl_b32 s42, s38, 20
  s_lshl_b32 s3, s39, 15
  s_sub_u32 s22, 0x100000, s3
  s_add_u32 s42, s42, s3
  s_mov_b32 s36, 0
  s_add_u32 s20, s6, s42
  s_addc_u32 s21, s7, 0
  s_add_u32 s24, s8, s42
  s_addc_u32 s25, s9, 0
  v_mov_b32 v8, v59
  v_subrev_u32 v7, 0x1f00, v7
  buffer_load_dwordx4 v[68:71], v8, s[20:23], s36 offen nt
  buffer_load_dwordx4 v[72:75], v8, s[20:23], s36 offen offset:2048 nt
  buffer_load_dwordx4 v[76:79], v8, s[20:23], s36 offen offset:1024 nt
  buffer_load_dwordx4 v[80:83], v8, s[20:23], s36 offen offset:3072 nt
  s_bitset1_b32 s36, 16
  buffer_load_dwordx4 v[84:87], v8, s[20:23], s36 offen nt
  buffer_load_dwordx4 v[88:91], v8, s[20:23], s36 offen offset:2048 nt
  buffer_load_dwordx4 v[92:95], v8, s[20:23], s36 offen offset:1024 nt
  buffer_load_dwordx4 v[96:99], v8, s[20:23], s36 offen offset:3072 nt
  s_or_b32 s36, s36, 0xfff1bfff
  s_add_u32 s36, s36, 1
  s_and_b32 s36, s36, 0xe4000
  s_waitcnt vmcnt(7)
  s_branch L_pass
L_kfar:
  s_cmp_eq_u32 s37, 0
  s_cbranch_scc1 L_kdone
  global_load_dword v49, v56, s[16:17] nt
  s_waitcnt vmcnt(7)
  buffer_load_dwordx4 v[68:71], v8, s[20:23], s36 offen nt
  v_dot2_f32_bf16 v1, v72, v72, 0
  v_add_f32_dpp v47, v47, v47 quad_perm:[1,0,3,2] row_mask:0xf bank_mask:0xf
  v_dot2_f32_bf16 v1, v73, v73, v1
  v_dot2_f32_bf16 v1, v74, v74, v1
  v_add_f32_dpp v47, v47, v47 quad_perm:[2,3,0,1] row_mask:0xf bank_mask:0xf
  v_dot2_f32_bf16 v1, v75, v75, v1
  v_add_f32_dpp v50, v61, v60 row_ror:12 row_mask:0xf bank_mask:0xf
  v_add_f32_dpp v47, v47, v47 row_half_mirror row_mask:0xf bank_mask:0xf
  v_add_f32_dpp v51, v64, v65 row_ror:4 row_mask:0xf bank_mask:0xf
  v_mfma_f32_16x16x4_f32 v[28:31], v1, v4, 0
  v_add_f32_dpp v50, v62, v50 row_ror:8 row_mask:0xf bank_mask:0xf
  v_add_f32_dpp v51, v66, v51 row_ror:12 row_mask:0xf bank_mask:0xf
  v_cvt_pk_bf16_f32 v44, v46, v47
  v_add_f32_dpp v2, v63, v50 row_ror:4 row_mask:0xf bank_mask:0x1
  v_mfma_f32_16x16x32_bf16 v[60:63], v[72:75], v[12:15], v[28:31]
  ds_write_b32 v7, v44 offset:0
  v_add_f32_dpp v2, v67, v51 row_ror:8 row_mask:0xf bank_mask:0x2
  v_mfma_f32_16x16x32_bf16 v[64:67], v[72:75], v[16:19], v[28:31]
  s_waitcnt vmcnt(7)
  buffer_load_dwordx4 v[72:75], v8, s[20:23], s36 offen offset:2048 nt
  v_dot2_f32_bf16 v1, v76, v76, 0
  v_dot2_f32_bf16 v1, v77, v77, v1
  v_dot2_f32_bf16 v1, v78, v78, v1
  v_dot2_f32_bf16 v1, v79, v79, v1
  s_nop 0
  v_add_f32_dpp v50, v60, v62 row_ror:8 row_mask:0xf bank_mask:0xf
  v_add_f32_dpp v51, v64, v67 row_ror:12 row_mask:0xf bank_mask:0xf
  v_mfma_f32_16x16x4_f32 v[28:31], v1, v4, 0
  v_add_f32_dpp v50, v61, v50 row_ror:4 row_mask:0xf bank_mask:0xf
  v_add_f32_dpp v51, v65, v51 row_ror:8 row_mask:0xf bank_mask:0xf
  s_nop 0
  v_add_f32_dpp v2, v63, v50 row_ror:12 row_mask:0xf bank_mask:0x4
  v_mfma_f32_16x16x32_bf16 v[60:63], v[76:79], v[12:15], v[28:31]
  s_nop 0
  v_add_f32_dpp v2, v66, v51 row_ror:4 row_mask:0xf bank_mask:0x8
  v_mul_f32 v2, s41, v2
  v_exp_f32 v2, v2
  v_mfma_f32_16x16x32_bf16 v[64:67], v[76:79], v[16:19], v[28:31]
  v_fma_f32 v46, v2, v5, v6
  v_add_f32 v3, v3, v46
  s_waitcnt vmcnt(7)
  buffer_load_dwordx4 v[76:79], v8, s[20:23], s36 offen offset:1024 nt
  v_dot2_f32_bf16 v1, v80, v80, 0
  v_add_f32_dpp v46, v46, v46 quad_perm:[1,0,3,2] row_mask:0xf bank_mask:0xf
  v_dot2_f32_bf16 v1, v81, v81, v1
  v_dot2_f32_bf16 v1, v82, v82, v1
  v_add_f32_dpp v46, v46, v46 quad_perm:[2,3,0,1] row_mask:0xf bank_mask:0xf
  v_dot2_f32_bf16 v1, v83, v83, v1
  v_add_f32_dpp v50, v61, v60 row_ror:12 row_mask:0xf bank_mask:0xf
  v_add_f32_dpp v46, v46, v46 row_half_mirror row_mask:0xf bank_mask:0xf
  v_add_f32_dpp v51, v64, v65 row_ror:4 row_mask:0xf bank_mask:0xf
  v_mfma_f32_16x16x4_f32 v[28:31], v1, v4, 0
  v_add_f32_dpp v50, v62, v50 row_ror:8 row_mask:0xf bank_mask:0xf
  v_add_f32_dpp v51, v66, v51 row_ror:12 row_mask:0xf bank_mask:0xf
  s_nop 0
  v_add_f32_dpp v2, v63, v50 row_ror:4 row_mask:0xf bank_mask:0x1
  v_mfma_f32_16x16x32_bf16 v[60:63], v[80:83], v[12:15], v[28:31]
  s_nop 0
  v_add_f32_dpp v2, v67, v51 row_ror:8 row_mask:0xf bank_mask:0x2
  v_mfma_f32_16x16x32_bf16 v[64:67], v[80:83], v[16:19], v[28:31]
  s_waitcnt vmcnt(7)
  buffer_load_dwordx4 v[80:83], v8, s[20:23], s36 offen offset:3072 nt
  s_bitset1_b32 s36, 16
  v_dot2_f32_bf16 v1, v84, v84, 0
  v_dot2_f32_bf16 v1, v85, v85, v1
  v_dot2_f32_bf16 v1, v86, v86, v1
  v_dot2_f32_bf16 v1, v87, v87, v1
  s_nop 0
  v_add_f32_dpp v50, v60, v62 row_ror:8 row_mask:0xf bank_mask:0xf
  v_add_f32_dpp v51, v64, v67 row_ror:12 row_mask:0xf bank_mask:0xf
  v_mfma_f32_16x16x4_f32 v[28:31], v1, v4, 0
  v_add_f32_dpp v50, v61, v50 row_ror:4 row_mask:0xf bank_mask:0xf
  v_add_f32_dpp v51, v65, v51 row_ror:8 row_mask:0xf bank_mask:0xf
  s_nop 0
  v_add_f32_dpp v2, v63, v50 row_ror:12 row_mask:0xf bank_mask:0x4
  v_mfma_f32_16x16x32_bf16 v[60:63], v[84:87], v[12:15], v[28:31]
  s_nop 0
  v_add_f32_dpp v2, v66, v51 row_ror:4 row_mask:0xf bank_mask:0x8
  v_mul_f32 v2, s41, v2
  v_exp_f32 v2, v2
  v_mfma_f32_16x16x32_bf16 v[64:67], v[84:87], v[16:19], v[28:31]
  v_fma_f32 v47, v2, v5, v6
  v_add_f32 v3, v3, v47
  s_waitcnt vmcnt(7)
  buffer_load_dwordx4 v[84:87], v8, s[20:23], s36 offen nt
  v_dot2_f32_bf16 v1, v88, v88, 0
  v_add_f32_dpp v47, v47, v47 quad_perm:[1,0,3,2] row_mask:0xf bank_mask:0xf
  v_dot2_f32_bf16 v1, v89, v89, v1
  v_dot2_f32_bf16 v1, v90, v90, v1
  v_add_f32_dpp v47, v47, v47 quad_perm:[2,3,0,1] row_mask:0xf bank_mask:0xf
  v_dot2_f32_bf16 v1, v91, v91, v1
  v_add_f32_dpp v50, v61, v60 row_ror:12 row_mask:0xf bank_mask:0xf
  v_add_f32_dpp v47, v47, v47 row_half_mirror row_mask:0xf bank_mask:0xf
  v_add_f32_dpp v51, v64, v65 row_ror:4 row_mask:0xf bank_mask:0xf
  v_mfma_f32_16x16x4_f32 v[28:31], v1, v4, 0
  v_add_f32_dpp v50, v62, v50 row_ror:8 row_mask:0xf bank_mask:0xf
  v_add_f32_dpp v51, v66, v51 row_ror:12 row_mask:0xf bank_mask:0xf
  v_cvt_pk_bf16_f32 v44, v46, v47
  v_add_f32_dpp v2, v63, v50 row_ror:4 row_mask:0xf bank_mask:0x1
  v_mfma_f32_16x16x32_bf16 v[60:63], v[88:91], v[12:15], v[28:31]
  ds_write_b32 v7, v44 offset:256
  v_add_f32_dpp v2, v67, v51 row_ror:8 row_mask:0xf bank_mask:0x2
  v_mfma_f32_16x16x32_bf16 v[64:67], v[88:91], v[16:19], v[28:31]
  s_waitcnt vmcnt(7)
  buffer_load_dwordx4 v[88:91], v8, s[20:23], s36 offen offset:2048 nt
  v_dot2_f32_bf16 v1, v92, v92, 0
  v_dot2_f32_bf16 v1, v93, v93, v1
  v_dot2_f32_bf16 v1, v94, v94, v1
  v_dot2_f32_bf16 v1, v95, v95, v1
  s_nop 0
  v_add_f32_dpp v50, v60, v62 row_ror:8 row_mask:0xf bank_mask:0xf
  v_add_f32_dpp v51, v64, v67 row_ror:12 row_mask:0xf bank_mask:0xf
  v_mfma_f32_16x16x4_f32 v[28:31], v1, v4, 0
  v_add_f32_dpp v50, v61, v50 row_ror:4 row_mask:0xf bank_mask:0xf
  v_add_f32_dpp v51, v65, v51 row_ror:8 row_mask:0xf bank_mask:0xf
  s_nop 0
  v_add_f32_dpp v2, v63, v50 row_ror:12 row_mask:0xf bank_mask:0x4
  v_mfma_f32_16x16x32_bf16 v[60:63], v[92:95], v[12:15], v[28:31]
  s_nop 0
  v_add_f32_dpp v2, v66, v51 row_ror:4 row_mask:0xf bank_mask:0x8
  v_mul_f32 v2, s41, v2
  v_exp_f32 v2, v2
  v_mfma_f32_16x16x32_bf16 v[64:67], v[92:95], v[16:19], v[28:31]
  v_fma_f32 v46, v2, v5, v6
  v_add_f32 v3, v3, v46
  s_waitcnt vmcnt(7)
  buffer_load_dwordx4 v[92:95], v8, s[20:23], s36 offen offset:1024 nt
  v_dot2_f32_bf16 v1, v96, v96, 0
  v_add_f32_dpp v46, v46, v46 quad_perm:[1,0,3,2] row_mask:0xf bank_mask:0xf
  v_dot2_f32_bf16 v1, v97, v97, v1
  v_dot2_f32_bf16 v1, v98, v98, v1
  v_add_f32_dpp v46, v46, v46 quad_perm:[2,3,0,1] row_mask:0xf bank_mask:0xf
  v_dot2_f32_bf16 v1, v99, v99, v1
  v_add_f32_dpp v50, v61, v60 row_ror:12 row_mask:0xf bank_mask:0xf
  v_add_f32_dpp v46, v46, v46 row_half_mirror row_mask:0xf bank_mask:0xf
  v_add_f32_dpp v51, v64, v65 row_ror:4 row_mask:0xf bank_mask:0xf
  v_mfma_f32_16x16x4_f32 v[28:31], v1, v4, 0
  v_add_f32_dpp v50, v62, v50 row_ror:8 row_mask:0xf bank_mask:0xf
  v_add_f32_dpp v51, v66, v51 row_ror:12 row_mask:0xf bank_mask:0xf
  s_nop 0
  v_add_f32_dpp v2, v63, v50 row_ror:4 row_mask:0xf bank_mask:0x1
  v_mfma_f32_16x16x32_bf16 v[60:63], v[96:99], v[12:15], v[28:31]
  s_nop 0
  v_add_f32_dpp v2, v67, v51 row_ror:8 row_mask:0xf bank_mask:0x2
  v_mfma_f32_16x16x32_bf16 v[64:67], v[96:99], v[16:19], v[28:31]
  s_waitcnt vmcnt(6)
  buffer_load_dwordx4 v[96:99], v8, s[20:23], s36 offen offset:3072 nt
  s_or_b32 s36, s36, 0xfff1bfff
  s_add_u32 s36, s36, 1
  s_and_b32 s36, s36, 0xe4000
  s_cmp_eq_u32 s37, 2
  s_cbranch_scc1 L_tov2
L_tov2_back:
  v_dot2_f32_bf16 v1, v68, v68, 0
  v_dot2_f32_bf16 v1, v69, v69, v1
  v_dot2_f32_bf16 v1, v70, v70, v1
  v_dot2_f32_bf16 v1, v71, v71, v1
  s_nop 0
  v_add_f32_dpp v50, v60, v62 row_ror:8 row_mask:0xf bank_mask:0xf
  v_add_f32_dpp v51, v64, v67 row_ror:12 row_mask:0xf bank_mask:0xf
  v_mfma_f32_16x16x4_f32 v[28:31], v1, v4, 0
  v_add_f32_dpp v50, v61, v50 row_ror:4 row_mask:0xf bank_mask:0xf
  v_add_f32_dpp v51, v65, v51 row_ror:8 row_mask:0xf bank_mask:0xf
  s_nop 0
  v_add_f32_dpp v2, v63, v50 row_ror:12 row_mask:0xf bank_mask:0x4
  v_mfma_f32_16x16x32_bf16 v[60:63], v[68:71], v[12:15], v[28:31]
  s_nop 0
  v_add_f32_dpp v2, v66, v51 row_ror:4 row_mask:0xf bank_mask:0x8
  v_mul_f32 v2, s41, v2
  v_exp_f32 v2, v2
  v_mfma_f32_16x16x32_bf16 v[64:67], v[68:71], v[16:19], v[28:31]
  v_fma_f32 v47, v2, v5, v6
  v_add_f32 v3, v3, v47
  s_branch L_kend
L_tov2:
  s_mov_b32 s20, s24
  s_mov_b32 s21, s25
  s_mov_b32 s36, 0
  v_mov_b32 v8, v48
  s_cmp_lg_u32 s27, 7
  s_cbranch_scc1 L_tov2_back
  s_mov_b32 s19, 1
  s_atomic_add s19, s[14:15], 0 glc
  s_branch L_tov2_back
L_vfar:
  s_cmp_eq_u32 s37, 1
  s_cbranch_scc1 L_vdone
  global_load_dword v49, v56, s[16:17] nt
  v_mfma_f32_16x16x32_bf16 v[36:39], v[32:35], v[68:71], v[36:39]
  s_waitcnt vmcnt(7)
  buffer_load_dwordx4 v[68:71], v8, s[20:23], s36 offen nt
  v_mfma_f32_16x16x32_bf16 v[40:43], v[32:35], v[72:75], v[40:43]
  v_perm_b32 v32, v44, v44, v24
  v_perm_b32 v33, v44, v44, v25
  v_perm_b32 v34, v44, v44, v26
  v_perm_b32 v35, v44, v44, v27
  ds_read_b32 v44, v7 offset:512
  s_waitcnt vmcnt(7)
  buffer_load_dwordx4 v[72:75], v8, s[20:23], s36 offen offset:2048 nt
  v_mfma_f32_16x16x32_bf16 v[36:39], v[32:35], v[76:79], v[36:39]
  s_waitcnt vmcnt(7)
  buffer_load_dwordx4 v[76:79], v8, s[20:23], s36 offen offset:1024 nt
  v_mfma_f32_16x16x32_bf16 v[40:43], v[32:35], v[80:83], v[40:43]
  s_waitcnt lgkmcnt(1)
  v_perm_b32 v32, v45, v45, v20
  v_perm_b32 v33, v45, v45, v21
  v_perm_b32 v34, v45, v45, v22
  v_perm_b32 v35, v45, v45, v23
  s_waitcnt vmcnt(7)
  buffer_load_dwordx4 v[80:83], v8, s[20:23], s36 offen offset:3072 nt
  s_bitset1_b32 s36, 16
  v_mfma_f32_16x16x32_bf16 v[36:39], v[32:35], v[84:87], v[36:39]
  s_waitcnt vmcnt(7)
  buffer_load_dwordx4 v[84:87], v8, s[20:23], s36 offen nt
  v_mfma_f32_16x16x32_bf16 v[40:43], v[32:35], v[88:91], v[40:43]
  v_perm_b32 v32, v45, v45, v24
  v_perm_b32 v33, v45, v45, v25
  v_perm_b32 v34, v45, v45, v26
  v_perm_b32 v35, v45, v45, v27
  ds_read_b32 v45, v7 offset:768
  s_waitcnt vmcnt(7)
  buffer_load_dwordx4 v[88:91], v8, s[20:23], s36 offen offset:2048 nt
  v_mfma_f32_16x16x32_bf16 v[36:39], v[32:35], v[92:95], v[36:39]
  s_waitcnt vmcnt(7)
  buffer_load_dwordx4 v[92:95], v8, s[20:23], s36 offen offset:1024 nt
  v_mfma_f32_16x16x32_bf16 v[40:43], v[32:35], v[96:99], v[40:43]
  s_waitcnt lgkmcnt(1)
  v_perm_b32 v32, v44, v44, v20
  v_perm_b32 v33, v44, v44, v21
  v_perm_b32 v34, v44, v44, v22
  v_perm_b32 v35, v44, v44, v23
  v_add_u32 v7, 512, v7
  s_sub_u32 s37, s37, 1
  s_waitcnt vmcnt(6)
  buffer_load_dwordx4 v[96:99], v8, s[20:23], s36 offen offset:3072 nt
  s_or_b32 s36, s36, 0xfff1bfff
  s_add_u32 s36, s36, 1
  s_and_b32 s36, s36, 0xe4000
  s_branch L_vend
.section .rodata,"a"
.p2align 6
.amdhsa_kernel standalone__linear_kernel_rfa__decode_kernel
  .amdhsa_next_free_vgpr 100
  .amdhsa_next_free_sgpr 58
  .amdhsa_accum_offset 100
  .amdhsa_group_segment_fixed_size 0
  .amdhsa_kernarg_size 56
  .amdhsa_user_sgpr_count 2
  .amdhsa_user_sgpr_kernarg_segment_ptr 1
  .amdhsa_system_sgpr_workgroup_id_x 1
.end_amdhsa_kernel
```
